```python
import torch

def _softmax(x, axis=-1):
    return torch.softmax(x, dim=axis)
def _gelu(x):
    return torch.nn.functional.gelu(x, approximate="tanh")
def _silu(x):
    return torch.nn.functional.silu(x)
def _sigmoid(x):
    return torch.sigmoid(x)
def _layernorm(x, axis=-1, eps=1e-5):
    m = x.mean(dim=axis, keepdim=True)
    v = x.var(dim=axis, keepdim=True, unbiased=False)
    return (x - m) / torch.sqrt(v + eps)
def _scatter_add(tgt, idx, src, axis=0):
    return tgt.clone().index_add_(axis, idx, src)
def _segment_sum(src, seg, n):
    out = torch.zeros((n,) + src.shape[1:], dtype=src.dtype)
    return out.index_add_(0, seg, src)
def _pad(x, pw):
    flat = tuple(v for pair in reversed(pw) for v in pair)
    return torch.nn.functional.pad(x, flat)

kernel_name = 'standalone__linear_kernel_rfa__decode'

def setup_inputs():

    _w = (lambda a: (lambda t: t.to(torch.bfloat16) if t.is_floating_point() else t)(torch.as_tensor(a)))
    B, H, Sq, Sk, D, M = 1, 32, 1, 32768, 128, 16
    return {
        "q": _w((lambda *s: torch.randn(*s, dtype=torch.bfloat16) * 0.4)(B, H, Sq, D)),
        "k": _w((lambda *s: torch.randn(*s, dtype=torch.bfloat16) * 1.6)(B, H, Sk, D)),
        "v": _w((lambda *s: torch.randn(*s, dtype=torch.bfloat16) * 1.6)(B, H, Sk, D)),
        "omega": _w((lambda *s: torch.randn(*s, dtype=torch.bfloat16) * 1.6)(M, D)),
    }

def reference(q, k, v, omega):
    d = q.shape[-1]
    m = omega.shape[0]
    scale = float(d) ** -0.25
    qs = q * scale
    ks = k * scale
    q_proj = torch.einsum("bhsd,md->bhsm", qs, omega)
    k_proj = torch.einsum("bhsd,md->bhsm", ks, omega)
    q_sq = 0.5 * torch.einsum("bhsd,bhsd->bhs", qs, qs)[..., None]
    k_sq = 0.5 * torch.einsum("bhsd,bhsd->bhs", ks, ks)[..., None]
    inv_sqrt_m = float(m) ** -0.5
    phi_q = torch.exp(q_proj - q_sq) * inv_sqrt_m + 1e-6
    phi_k = torch.exp(k_proj - k_sq) * inv_sqrt_m + 1e-6
    kv = torch.einsum("bhsm,bhsd->bhmd", phi_k, v)
    z  = torch.einsum("bhsm->bhm", phi_k)
    num = torch.einsum("bhqm,bhmd->bhqd", phi_q, kv)
    den = torch.einsum("bhqm,bhm->bhq", phi_q, z)[..., None] + 1e-6
    return num / den
```

```asm
; @launch grid=(256,1,1) block=(320,1,1) lds=151680
.amdgcn_target "amdgcn-amd-amdhsa--gfx950"
.text
.p2align 12
.globl standalone__linear_kernel_rfa__decode_kernel
.p2align 8
.type standalone__linear_kernel_rfa__decode_kernel,@function
standalone__linear_kernel_rfa__decode_kernel:
  s_load_dwordx2 s[8:9], s[0:1], 8
  s_load_dwordx8 s[72:79], s[0:1], 16
  s_load_dwordx2 s[24:25], s[0:1], 48
  s_cmpk_ge_u32 s2, 256
  s_cbranch_scc1 L_end
  v_lshrrev_b32 v1, 6, v0
  v_and_b32 v0, 63, v0
  v_readfirstlane_b32 s3, v1
  v_lshrrev_b32 v25, 4, v0
  v_xor_b32 v2, v0, v25
  v_lshlrev_b32 v2, 4, v2
  v_xor_b32 v3, 1088, v2
  v_xor_b32 v4, 2176, v2
  v_xor_b32 v5, 3264, v2
  s_lshr_b32 s39, s2, 2
  s_xor_b32 s39, s39, s2
  s_and_b32 s39, s39, 2
  s_mul_i32 s39, s39, 5
  s_xor_b32 s2, s2, s39
  s_lshr_b32 s39, s2, 3
  s_mov_b32 s11, 0x20000
  s_cmp_lg_u32 s3, 0
  s_cbranch_scc1 L_cons
  s_setprio 3
  s_brev_b32 s10, 8
  s_lshr_b32 s37, s2, 1
  s_lshl_b32 s37, s37, 21
  s_and_b32 s45, s2, 1
  s_lshl_b32 s45, s45, 14
  s_or_b32 s37, s37, s45
  s_mov_b32 m0, 0
  s_movk_i32 s56, 4096
  s_movk_i32 s36, 3072
  s_mov_b64 vcc, 0
  s_mov_b32 s38, 0
  s_mov_b32 s53, 0
  s_waitcnt lgkmcnt(0)
L_k:
  s_and_b32 s16, s38, 3
  s_and_b32 s17, s38, 12
  s_lshr_b32 s18, s38, 4
  s_lshl2_add_u32 s16, s17, s16
  s_lshl2_add_u32 s16, s18, s16
  s_lshl_b32 s16, s16, 15
  s_add_u32 s16, s16, s37
  s_add_u32 s38, s38, 1
  s_add_u32 s17, s16, s36
  s_add_u32 s18, s17, s36
  s_add_u32 s19, s18, s36
  s_waitcnt vmcnt(20)
  buffer_load_dwordx4 v2, s[8:11], s16 offen offset:0 nt lds
  s_waitcnt vmcnt(20)
  buffer_load_dwordx4 v2, s[8:11], s17 offen offset:1024 nt lds
  s_waitcnt vmcnt(20)
  buffer_load_dwordx4 v2, s[8:11], s18 offen offset:2048 nt lds
  s_waitcnt vmcnt(20)
  buffer_load_dwordx4 v2, s[8:11], s19 offen offset:3072 nt lds
  s_add_u32 m0, m0, s56
  s_waitcnt vmcnt(20)
  s_cbranch_vccz L_nb1
  s_barrier
L_nb1:
  buffer_load_dwordx4 v3, s[8:11], s16 offen offset:0 nt lds
  s_waitcnt vmcnt(20)
  buffer_load_dwordx4 v3, s[8:11], s17 offen offset:1024 nt lds
  s_waitcnt vmcnt(20)
  buffer_load_dwordx4 v3, s[8:11], s18 offen offset:2048 nt lds
  s_waitcnt vmcnt(20)
  buffer_load_dwordx4 v3, s[8:11], s19 offen offset:3072 nt lds
  s_add_u32 m0, m0, s56
  s_waitcnt vmcnt(20)
  buffer_load_dwordx4 v4, s[8:11], s16 offen offset:0 nt lds
  s_waitcnt vmcnt(20)
  buffer_load_dwordx4 v4, s[8:11], s17 offen offset:1024 nt lds
  s_waitcnt vmcnt(20)
  buffer_load_dwordx4 v4, s[8:11], s18 offen offset:2048 nt lds
  s_waitcnt vmcnt(20)
  buffer_load_dwordx4 v4, s[8:11], s19 offen offset:3072 nt lds
  s_add_u32 m0, m0, s56
  s_waitcnt vmcnt(20)
  buffer_load_dwordx4 v5, s[8:11], s16 offen offset:0 nt lds
  s_waitcnt vmcnt(20)
  buffer_load_dwordx4 v5, s[8:11], s17 offen offset:1024 nt lds
  s_waitcnt vmcnt(20)
  buffer_load_dwordx4 v5, s[8:11], s18 offen offset:2048 nt lds
  s_waitcnt vmcnt(20)
  buffer_load_dwordx4 v5, s[8:11], s19 offen offset:3072 nt lds
  s_add_u32 m0, m0, s56
  s_bitset0_b32 m0, 17
  s_cmp_lg_u32 s53, 0
  s_cbranch_scc1 L_dv
  s_cmp_ge_u32 s38, 6
  s_cselect_b64 vcc, -1, 0
  s_cmp_eq_u32 s38, 4
  s_cselect_b64 vcc, -1, vcc
  s_cmp_lt_u32 s38, 61
  s_cbranch_scc1 L_k
  s_mov_b64 s[12:13], s[72:73]
  s_mov_b64 s[14:15], s[10:11]
  v_lshlrev_b32 v6, 4, v0
  v_add_u32 v7, 1024, v6
  v_add_u32 v8, 2048, v6
  v_add_u32 v9, 3072, v6
  s_mov_b32 s54, s16
  s_mov_b32 s38, 0
  s_mov_b32 s26, 0x100000
  s_mov_b32 s27, s11
  s_mul_i32 s61, s39, 4352
  s_add_u32 s61, s61, 262144
  s_add_u32 s64, s24, s61
  s_addc_u32 s65, s25, 0
  s_mov_b32 s59, 0
  s_mov_b32 s60, 61
L_v:
  s_and_b32 s16, s38, 3
  s_and_b32 s17, s38, 12
  s_lshr_b32 s18, s38, 4
  s_lshl2_add_u32 s16, s17, s16
  s_lshl2_add_u32 s16, s18, s16
  s_lshl_b32 s16, s16, 15
  s_add_u32 s16, s16, s37
  s_add_u32 s38, s38, 1
  s_sub_u32 s45, s38, 10
  s_cmp_lt_u32 s45, 4
  s_cselect_b64 vcc, -1, 0
  s_cmp_eq_u32 s38, 24
  s_cbranch_scc0 L_v0
  s_load_dwordx2 s[62:63], s[78:79], 8
L_v0:
  s_cmp_eq_u32 s38, 59
  s_cbranch_scc0 L_v1
  s_waitcnt lgkmcnt(0)
  s_cmp_eq_u32 s63, 1
  s_cbranch_scc0 L_slow
L_rdy:
  s_mov_b32 s58, 1
  s_atomic_add s58, s[64:65], 0 glc
L_v1:
  s_add_u32 s17, s16, s36
  s_add_u32 s18, s17, s36
  s_add_u32 s19, s18, s36
  s_waitcnt vmcnt(20)
  buffer_load_dwordx4 v6, s[12:15], s16 offen offset:0 nt lds
  s_waitcnt vmcnt(20)
  buffer_load_dwordx4 v6, s[12:15], s17 offen offset:1024 nt lds
  s_waitcnt vmcnt(20)
  buffer_load_dwordx4 v6, s[12:15], s18 offen offset:2048 nt lds
  s_waitcnt vmcnt(20)
  buffer_load_dwordx4 v6, s[12:15], s19 offen offset:3072 nt lds
  s_add_u32 m0, m0, s56
  s_waitcnt vmcnt(20)
  s_barrier
  buffer_load_dwordx4 v7, s[12:15], s16 offen offset:0 nt lds
  s_waitcnt vmcnt(20)
  buffer_load_dwordx4 v7, s[12:15], s17 offen offset:1024 nt lds
  s_waitcnt vmcnt(20)
  buffer_load_dwordx4 v7, s[12:15], s18 offen offset:2048 nt lds
  s_waitcnt vmcnt(20)
  buffer_load_dwordx4 v7, s[12:15], s19 offen offset:3072 nt lds
  s_add_u32 m0, m0, s56
  s_waitcnt vmcnt(20)
  buffer_load_dwordx4 v8, s[12:15], s16 offen offset:0 nt lds
  s_waitcnt vmcnt(20)
  buffer_load_dwordx4 v8, s[12:15], s17 offen offset:1024 nt lds
  s_waitcnt vmcnt(20)
  buffer_load_dwordx4 v8, s[12:15], s18 offen offset:2048 nt lds
  s_waitcnt vmcnt(20)
  buffer_load_dwordx4 v8, s[12:15], s19 offen offset:3072 nt lds
  s_add_u32 m0, m0, s56
  s_waitcnt vmcnt(20)
  s_cbranch_vccz L_nb2
  s_barrier
L_nb2:
  buffer_load_dwordx4 v9, s[12:15], s16 offen offset:0 nt lds
  s_waitcnt vmcnt(20)
  buffer_load_dwordx4 v9, s[12:15], s17 offen offset:1024 nt lds
  s_waitcnt vmcnt(20)
  buffer_load_dwordx4 v9, s[12:15], s18 offen offset:2048 nt lds
  s_waitcnt vmcnt(20)
  buffer_load_dwordx4 v9, s[12:15], s19 offen offset:3072 nt lds
  s_add_u32 m0, m0, s56
  s_bitset0_b32 m0, 17
  s_cmp_eq_u32 s53, 2
  s_cbranch_scc1 L_fin
  s_cmp_lt_u32 s38, 60
  s_cbranch_scc1 L_v
  s_mov_b32 s53, 1
  s_mov_b64 vcc, -1
  s_cmp_lg_u32 s59, 0
  s_cbranch_scc1 L_d2
  s_waitcnt lgkmcnt(0)
  s_cmp_lt_u32 s58, 16
  s_cbranch_scc0 L_last
  s_lshr_b32 s45, s58, 3
  s_lshl_b32 s45, s45, 2
  s_lshr_b32 s59, 18, s45
  s_and_b32 s59, s59, 15
  s_lshr_b32 s38, 32, s45
  s_and_b32 s38, s38, 15
  s_add_u32 s38, s38, 61
  s_bfe_u32 s45, s58, 0x20001
  s_lshl2_add_u32 s37, s39, s45
  s_lshl_b32 s37, s37, 21
  s_and_b32 s45, s58, 1
  s_lshl_b32 s45, s45, 14
  s_or_b32 s37, s37, s45
L_d2:
  s_add_u32 s60, s60, 1
  s_sub_u32 s59, s59, 1
  s_cmp_lg_u32 s59, 0
  s_cbranch_scc1 L_k
  s_mov_b32 s58, 1
  s_atomic_add s58, s[64:65], 0 glc
  s_branch L_k
L_last:
  v_mov_b32 v24, s60
  v_mov_b32 v110, 151616
  ds_write_b32 v110, v24
  s_mov_b32 s53, 2
  s_waitcnt lgkmcnt(0)
L_dv:
  s_mov_b32 s45, s16
  s_mov_b32 s16, s54
  s_mov_b32 s54, s45
  s_mov_b64 vcc, 0
  s_branch L_v1
L_fin:
  s_lshl_b32 s80, s2, 10
  v_mov_b32 v25, 1
  v_mov_b32 v115, 4
  buffer_load_dwordx4 v[64:67], v6, s[24:27], s80 offen
  s_mov_b64 exec, 1
  buffer_atomic_add v25, v115, s[24:27], s61 offen sc0
  s_mov_b64 exec, -1
  s_waitcnt vmcnt(18)
  s_barrier
  s_xor_b32 s81, s80, 1024
  s_xor_b32 s82, s80, 2048
  s_xor_b32 s83, s80, 3072
  s_xor_b32 s84, s80, 4096
  s_xor_b32 s85, s80, 5120
  s_xor_b32 s86, s80, 6144
  s_xor_b32 s87, s80, 7168
  s_mov_b64 s[28:29], s[76:77]
  s_movk_i32 s30, 8192
  s_mov_b32 s31, s11
  s_lshl_b32 s44, s39, 8
  s_mov_b32 s49, 0x100000
  v_mov_b32 v31, s62
  v_lshlrev_b32 v111, 3, v0
  v_add_u32 v111, 147456, v111
  v_mov_b32 v112, 151552
  v_lshlrev_b32 v114, 2, v0
  s_waitcnt vmcnt(2)
  s_barrier
  ds_read_b128 v[48:51], v112 offset:0
  ds_read_b128 v[52:55], v112 offset:16
  ds_read_b128 v[56:59], v112 offset:32
  ds_read_b128 v[60:63], v112 offset:48
  s_waitcnt lgkmcnt(0)
  v_pk_add_f32 v[48:49], v[48:49], v[50:51]
  v_pk_add_f32 v[52:53], v[52:53], v[54:55]
  v_pk_add_f32 v[56:57], v[56:57], v[58:59]
  v_pk_add_f32 v[60:61], v[60:61], v[62:63]
  v_pk_add_f32 v[48:49], v[48:49], v[52:53]
  v_pk_add_f32 v[56:57], v[56:57], v[60:61]
  v_pk_add_f32 v[48:49], v[48:49], v[56:57]
  v_add_f32 v30, v48, v49
  s_waitcnt vmcnt(0)
  v_readfirstlane_b32 s55, v25
  s_nop 0
  s_cmp_eq_u32 s55, 7
  s_barrier
  ds_read_b64 v[32:33], v111 offset:0
  ds_read_b64 v[34:35], v111 offset:512
  ds_read_b64 v[36:37], v111 offset:1024
  ds_read_b64 v[38:39], v111 offset:1536
  ds_read_b64 v[40:41], v111 offset:2048
  ds_read_b64 v[42:43], v111 offset:2560
  ds_read_b64 v[44:45], v111 offset:3072
  ds_read_b64 v[46:47], v111 offset:3584
  s_waitcnt lgkmcnt(6)
  v_pk_add_f32 v[32:33], v[32:33], v[34:35]
  s_waitcnt lgkmcnt(4)
  v_pk_add_f32 v[36:37], v[36:37], v[38:39]
  v_pk_add_f32 v[32:33], v[32:33], v[36:37]
  s_waitcnt lgkmcnt(2)
  v_pk_add_f32 v[40:41], v[40:41], v[42:43]
  s_waitcnt lgkmcnt(0)
  v_pk_add_f32 v[44:45], v[44:45], v[46:47]
  v_pk_add_f32 v[40:41], v[40:41], v[44:45]
  v_pk_add_f32 v[28:29], v[32:33], v[40:41]
  s_cbranch_scc1 L_poll
  buffer_store_dwordx4 v[28:31], v6, s[24:27], s80 offen sc1
  s_endpgm
L_poll:
  buffer_load_dwordx4 v[68:71], v6, s[24:27], s81 offen sc1
  buffer_load_dwordx4 v[72:75], v6, s[24:27], s82 offen sc1
  buffer_load_dwordx4 v[76:79], v6, s[24:27], s83 offen sc1
  buffer_load_dwordx4 v[80:83], v6, s[24:27], s84 offen sc1
  buffer_load_dwordx4 v[84:87], v6, s[24:27], s85 offen sc1
  buffer_load_dwordx4 v[88:91], v6, s[24:27], s86 offen sc1
  buffer_load_dwordx4 v[92:95], v6, s[24:27], s87 offen sc1
  s_sub_u32 s49, s49, 1
  s_cbranch_scc1 L_end
  v_add_f32 v66, 0x358637bd, v30
  s_waitcnt vmcnt(6)
  v_xor_b32 v24, v31, v71
  v_add_f32 v66, v66, v70
  v_pk_add_f32 v[64:65], v[28:29], v[68:69]
  s_waitcnt vmcnt(5)
  v_bitop3_b32 v24, v24, v75, v31 bitop3:0xf6
  v_add_f32 v66, v66, v74
  v_pk_add_f32 v[64:65], v[64:65], v[72:73]
  s_waitcnt vmcnt(4)
  v_bitop3_b32 v24, v24, v79, v31 bitop3:0xf6
  v_add_f32 v66, v66, v78
  v_pk_add_f32 v[64:65], v[64:65], v[76:77]
  s_waitcnt vmcnt(3)
  v_bitop3_b32 v24, v24, v83, v31 bitop3:0xf6
  v_add_f32 v66, v66, v82
  v_pk_add_f32 v[64:65], v[64:65], v[80:81]
  s_waitcnt vmcnt(2)
  v_bitop3_b32 v24, v24, v87, v31 bitop3:0xf6
  v_add_f32 v66, v66, v86
  v_pk_add_f32 v[64:65], v[64:65], v[84:85]
  s_waitcnt vmcnt(1)
  v_bitop3_b32 v24, v24, v91, v31 bitop3:0xf6
  v_add_f32 v66, v66, v90
  v_pk_add_f32 v[64:65], v[64:65], v[88:89]
  s_waitcnt vmcnt(0)
  v_bitop3_b32 v24, v24, v95, v31 bitop3:0xf6
  v_add_f32 v66, v66, v94
  v_cmp_ne_u32 vcc, 0, v24
  v_rcp_f32 v67, v66
  v_pk_add_f32 v[64:65], v[64:65], v[92:93]
  v_mul_f32 v68, v64, v67
  v_mul_f32 v69, v65, v67
  v_fma_f32 v70, -v68, v66, v64
  v_fma_f32 v71, -v69, v66, v65
  v_fma_f32 v68, v70, v67, v68
  v_fma_f32 v69, v71, v67, v69
  s_cbranch_vccnz L_poll
  v_cvt_pk_bf16_f32 v64, v68, v69
  buffer_store_dword v64, v114, s[28:31], s44 offen
L_end:
  s_endpgm
.p2align 5
L_K:
  v_add_u32 v114, s50, v104
  v_add_u32 v115, s50, v105
  v_add_u32 v116, s50, v106
  v_add_u32 v117, s50, v107
  s_barrier
L_K1:
  ds_read_b128 v[48:51], v114
  ds_read_b128 v[52:55], v115
  ds_read_b128 v[56:59], v116
  ds_read_b128 v[60:63], v117
  s_addk_i32 s50, 0x4000
  s_bitset0_b32 s50, 17
  s_and_b32 s45, s51, 63
  s_lshl_b32 s45, s45, 8
  v_add_u32 v114, s45, v109
  s_waitcnt lgkmcnt(3)
  v_lshlrev_b32 v24, 16, v48
  v_and_b32 v25, s43, v48
  v_lshlrev_b32 v26, 16, v49
  v_and_b32 v27, s43, v49
  v_lshlrev_b32 v28, 16, v50
  v_and_b32 v29, s43, v50
  v_lshlrev_b32 v30, 16, v51
  v_and_b32 v31, s43, v51
  v_pk_mul_f32 v[24:25], v[24:25], s[40:41]
  v_pk_mul_f32 v[26:27], v[26:27], s[40:41]
  v_pk_mul_f32 v[28:29], v[28:29], s[40:41]
  v_pk_mul_f32 v[30:31], v[30:31], s[40:41]
  v_cvt_pk_bf16_f32 v32, v24, v25
  v_cvt_pk_bf16_f32 v33, v26, v27
  v_cvt_pk_bf16_f32 v34, v28, v29
  v_cvt_pk_bf16_f32 v35, v30, v31
  s_waitcnt lgkmcnt(2)
  v_lshlrev_b32 v24, 16, v52
  v_and_b32 v25, s43, v52
  v_lshlrev_b32 v26, 16, v53
  v_and_b32 v27, s43, v53
  v_lshlrev_b32 v28, 16, v54
  v_and_b32 v29, s43, v54
  v_lshlrev_b32 v30, 16, v55
  v_and_b32 v31, s43, v55
  v_pk_mul_f32 v[24:25], v[24:25], s[40:41]
  v_pk_mul_f32 v[26:27], v[26:27], s[40:41]
  v_pk_mul_f32 v[28:29], v[28:29], s[40:41]
  v_pk_mul_f32 v[30:31], v[30:31], s[40:41]
  v_cvt_pk_bf16_f32 v36, v24, v25
  v_cvt_pk_bf16_f32 v37, v26, v27
  v_cvt_pk_bf16_f32 v38, v28, v29
  v_cvt_pk_bf16_f32 v39, v30, v31
  v_mfma_f32_16x16x32_bf16 v[68:71], v[32:35], v[32:35], 0
  v_mfma_f32_16x16x32_bf16 v[64:67], a[0:3], v[32:35], 0
  s_waitcnt lgkmcnt(1)
  v_lshlrev_b32 v24, 16, v56
  v_and_b32 v25, s43, v56
  v_lshlrev_b32 v26, 16, v57
  v_and_b32 v27, s43, v57
  v_lshlrev_b32 v28, 16, v58
  v_and_b32 v29, s43, v58
  v_lshlrev_b32 v30, 16, v59
  v_and_b32 v31, s43, v59
  v_pk_mul_f32 v[24:25], v[24:25], s[40:41]
  v_pk_mul_f32 v[26:27], v[26:27], s[40:41]
  v_pk_mul_f32 v[28:29], v[28:29], s[40:41]
  v_pk_mul_f32 v[30:31], v[30:31], s[40:41]
  v_cvt_pk_bf16_f32 v40, v24, v25
  v_cvt_pk_bf16_f32 v41, v26, v27
  v_cvt_pk_bf16_f32 v42, v28, v29
  v_cvt_pk_bf16_f32 v43, v30, v31
  v_mfma_f32_16x16x32_bf16 v[68:71], v[36:39], v[36:39], v[68:71]
  v_mfma_f32_16x16x32_bf16 v[64:67], a[4:7], v[36:39], v[64:67]
  s_waitcnt lgkmcnt(0)
  v_lshlrev_b32 v24, 16, v60
  v_and_b32 v25, s43, v60
  v_lshlrev_b32 v26, 16, v61
  v_and_b32 v27, s43, v61
  v_lshlrev_b32 v28, 16, v62
  v_and_b32 v29, s43, v62
  v_lshlrev_b32 v30, 16, v63
  v_and_b32 v31, s43, v63
  v_pk_mul_f32 v[24:25], v[24:25], s[40:41]
  v_pk_mul_f32 v[26:27], v[26:27], s[40:41]
  v_pk_mul_f32 v[28:29], v[28:29], s[40:41]
  v_pk_mul_f32 v[30:31], v[30:31], s[40:41]
  v_cvt_pk_bf16_f32 v44, v24, v25
  v_cvt_pk_bf16_f32 v45, v26, v27
  v_cvt_pk_bf16_f32 v46, v28, v29
  v_cvt_pk_bf16_f32 v47, v30, v31
  v_mfma_f32_16x16x32_bf16 v[68:71], v[40:43], v[40:43], v[68:71]
  v_mfma_f32_16x16x32_bf16 v[64:67], a[8:11], v[40:43], v[64:67]
  v_mfma_f32_16x16x32_bf16 v[68:71], v[44:47], v[44:47], v[68:71]
  v_mfma_f32_16x16x32_bf16 v[64:67], a[12:15], v[44:47], v[64:67]
  s_nop 6
  v_and_b32 v24, v68, v10
  v_and_or_b32 v24, v69, v11, v24
  v_and_or_b32 v24, v70, v12, v24
  v_and_or_b32 v24, v71, v13, v24
  v_cvt_pk_bf16_f32 v64, 0, v64
  v_cvt_pk_bf16_f32 v65, 0, v65
  v_mfma_f32_16x16x4_f32 v[72:75], v18, v24, 0
  v_cvt_pk_bf16_f32 v66, 0, v66
  v_cvt_pk_bf16_f32 v67, 0, v67
  s_nop 7
  v_cvt_pk_bf16_f32 v24, 0, v72
  v_fma_f32 v64, v24, -0.5, v64
  v_fma_f32 v65, v24, -0.5, v65
  v_fma_f32 v66, v24, -0.5, v66
  v_fma_f32 v67, v24, -0.5, v67
  v_cvt_pk_bf16_f32 v64, 0, v64
  v_cvt_pk_bf16_f32 v65, 0, v65
  v_cvt_pk_bf16_f32 v66, 0, v66
  v_cvt_pk_bf16_f32 v67, 0, v67
  v_fma_f32 v64, v64, s42, -2.0
  v_fma_f32 v65, v65, s42, -2.0
  v_fma_f32 v66, v66, s42, -2.0
  v_fma_f32 v67, v67, s42, -2.0
  v_exp_f32 v64, v64
  v_exp_f32 v65, v65
  v_exp_f32 v66, v66
  v_exp_f32 v67, v67
  s_add_u32 s51, s51, 1
  v_cvt_pk_bf16_f32 v64, 0, v64
  v_cvt_pk_bf16_f32 v65, 0, v65
  v_cvt_pk_bf16_f32 v66, 0, v66
  v_cvt_pk_bf16_f32 v67, 0, v67
  v_add_f32 v64, s47, v64
  v_add_f32 v65, s47, v65
  v_add_f32 v66, s47, v66
  v_add_f32 v67, s47, v67
  v_cvt_pk_bf16_f32 v22, v64, v65
  v_cvt_pk_bf16_f32 v23, v66, v67
  s_cmp_eq_u32 s51, 0
  s_cbranch_scc1 L_Q
  v_mfma_f32_16x16x16_bf16 v[76:79], v[22:23], v[20:21], 0
  v_mfma_f32_16x16x16_bf16 v[80:83], v[22:23], v[20:21], v[80:83]
  s_cmp_lt_u32 s51, 61
  s_nop 5
  ds_write_b128 v114, v[76:79]
  s_cbranch_scc1 L_K
L_V:
  s_and_b32 s45, s52, 63
  s_lshl_b32 s45, s45, 8
  v_add_u32 v114, s45, v109
  ds_read_b128 v[76:79], v114
  v_add_u32 v115, s50, v108
  s_addk_i32 s50, 0x4000
  s_bitset0_b32 s50, 17
  s_add_u32 s52, s52, 1
  s_waitcnt lgkmcnt(0)
  v_cvt_pk_bf16_f32 v24, 0, v76
  v_cvt_pk_bf16_f32 v25, 0, v77
  v_cvt_pk_bf16_f32 v26, 0, v78
  v_cvt_pk_bf16_f32 v27, 0, v79
  v_fma_f32 v24, v24, v19, v76
  v_fma_f32 v25, v25, v19, v77
  v_fma_f32 v26, v26, v19, v78
  v_fma_f32 v27, v27, v19, v79
  v_cvt_pk_bf16_f32 v24, v24, v24
  v_cvt_pk_bf16_f32 v25, v25, v25
  v_cvt_pk_bf16_f32 v26, v26, v26
  v_cvt_pk_bf16_f32 v27, v27, v27
  v_and_b32 v88, v24, v14
  v_and_b32 v89, v24, v15
  v_and_b32 v90, v24, v16
  v_and_b32 v91, v24, v17
  v_and_b32 v92, v25, v14
  v_and_b32 v93, v25, v15
  v_and_b32 v94, v25, v16
  v_and_b32 v95, v25, v17
  v_and_b32 v96, v26, v14
  v_and_b32 v97, v26, v15
  v_and_b32 v98, v26, v16
  v_and_b32 v99, v26, v17
  v_and_b32 v100, v27, v14
  v_and_b32 v101, v27, v15
  v_and_b32 v102, v27, v16
  v_and_b32 v103, v27, v17
  s_barrier
  ds_read_b128 v[48:51], v115 offset:0
  ds_read_b128 v[52:55], v115 offset:256
  ds_read_b128 v[56:59], v115 offset:512
  ds_read_b128 v[60:63], v115 offset:768
  ds_read_b32 v24, v110
  s_cmp_eq_u32 s52, s51
  s_waitcnt lgkmcnt(4)
  v_mfma_f32_16x16x32_bf16 v[84:87], v[88:91], v[48:51], v[84:87]
  s_waitcnt lgkmcnt(3)
  v_mfma_f32_16x16x32_bf16 v[84:87], v[92:95], v[52:55], v[84:87]
  s_waitcnt lgkmcnt(2)
  v_mfma_f32_16x16x32_bf16 v[84:87], v[96:99], v[56:59], v[84:87]
  s_waitcnt lgkmcnt(1)
  v_mfma_f32_16x16x32_bf16 v[84:87], v[100:103], v[60:63], v[84:87]
  s_cbranch_scc0 L_V2
  s_nop 6
  ds_write_b128 v111, v[84:87]
  s_waitcnt lgkmcnt(0)
  s_barrier
  s_endpgm
L_V2:
  s_waitcnt lgkmcnt(0)
  v_readfirstlane_b32 s46, v24
  s_add_u32 s45, s52, 1
  s_cmp_lt_u32 s45, s51
  s_cbranch_scc1 L_V
  s_cmp_eq_u32 s46, s51
  s_cbranch_scc0 L_K
  v_add_f32 v72, v80, v81
  v_add_f32 v73, v82, v83
  v_add_f32 v72, v72, v73
  ds_write_b32 v112, v72
  s_branch L_V
L_Q:
  v_mov_b32 v20, v22
  v_mov_b32 v21, v23
  s_lshl_b32 s50, s3, 10
  s_branch L_K
L_hotend:
L_cons:
  s_sub_u32 s3, s3, 1
  s_load_dwordx2 s[20:21], s[0:1], 0
  s_movk_i32 s18, 4096
  s_mov_b32 s19, s11
  s_movk_i32 s22, 8192
  s_mov_b32 s23, s11
  s_mov_b32 s26, 0x100000
  s_mov_b32 s27, s11
  s_lshl_b32 s44, s39, 8
  v_mov_b32 v110, 151616
  v_mov_b32 v80, 0
  v_mov_b32 v84, 0
  v_mov_b32 v81, 0
  v_mov_b32 v85, 0
  v_mov_b32 v82, 0
  v_mov_b32 v86, 0
  v_mov_b32 v83, 0
  v_mov_b32 v87, 0
  s_waitcnt lgkmcnt(0)
  s_mov_b64 s[16:17], s[74:75]
  s_cmp_eq_u32 s3, 0
  s_cbranch_scc0 L_c1
  s_mov_b32 m0, 114688
  s_nop 0
  buffer_load_dwordx4 v2, s[16:19], 0 offen lds
  s_mov_b32 m0, 118784
  s_nop 0
  buffer_load_dwordx4 v3, s[16:19], 0 offen lds
  s_mov_b32 m0, 122880
  s_nop 0
  buffer_load_dwordx4 v4, s[16:19], 0 offen lds
  s_mov_b32 m0, 126976
  s_nop 0
  buffer_load_dwordx4 v5, s[16:19], 0 offen lds
  s_cmp_eq_u32 s2, 0
  s_cbranch_scc0 L_c3
  s_call_b64 s[66:67], L_init
  s_branch L_c3
L_c1:
  s_cmp_eq_u32 s3, 1
  s_cbranch_scc0 L_c2
  s_mov_b32 m0, 115712
  v_and_b32 v2, 0xff, v2
  buffer_load_dwordx4 v2, s[20:23], s44 offen lds
  s_mov_b32 m0, 119808
  v_and_b32 v3, 0xff, v3
  buffer_load_dwordx4 v3, s[20:23], s44 offen lds
  s_mov_b32 m0, 123904
  v_and_b32 v4, 0xff, v4
  buffer_load_dwordx4 v4, s[20:23], s44 offen lds
  s_mov_b32 m0, 128000
  v_and_b32 v5, 0xff, v5
  buffer_load_dwordx4 v5, s[20:23], s44 offen lds
  s_branch L_c3
L_c2:
  s_cmp_eq_u32 s3, 2
  s_cbranch_scc0 L_c4
  ds_write_b32 v110, v80
  s_branch L_c3
L_c4:
L_c3:
  s_mov_b32 s40, 0x3e9837f0
  s_mov_b32 s41, s40
  s_mov_b32 s42, 0x3fb8aa3b
  s_mov_b32 s43, 0xffff0000
  s_mov_b32 s47, 0x358637bd
  v_and_b32 v24, 15, v0
  v_lshlrev_b32 v26, 2, v25
  v_sub_u32 v26, v24, v26
  v_cmp_eq_u32 vcc, 0, v26
  s_nop 1
  v_cndmask_b32 v10, 0, -1, vcc
  v_cmp_eq_u32 vcc, 1, v26
  s_nop 1
  v_cndmask_b32 v11, 0, -1, vcc
  v_cmp_eq_u32 vcc, 2, v26
  s_nop 1
  v_cndmask_b32 v12, 0, -1, vcc
  v_cmp_eq_u32 vcc, 3, v26
  s_nop 1
  v_cndmask_b32 v13, 0, -1, vcc
  v_and_b32 v27, 1, v24
  v_cmp_eq_u32 vcc, 1, v27
  v_mov_b32 v28, 0xffff
  v_mov_b32 v29, s43
  v_cndmask_b32 v28, v28, v29, vcc
  v_bfe_u32 v27, v24, 1, 2
  v_cmp_eq_u32 vcc, 0, v27
  s_nop 1
  v_cndmask_b32 v14, 0, v28, vcc
  v_cmp_eq_u32 vcc, 1, v27
  s_nop 1
  v_cndmask_b32 v15, 0, v28, vcc
  v_cmp_eq_u32 vcc, 2, v27
  s_nop 1
  v_cndmask_b32 v16, 0, v28, vcc
  v_cmp_eq_u32 vcc, 3, v27
  s_nop 1
  v_cndmask_b32 v17, 0, v28, vcc
  v_mov_b32 v18, 1.0
  v_cmp_lt_u32 vcc, 7, v24
  s_nop 1
  v_cndmask_b32 v19, 0, -1.0, vcc
  v_lshrrev_b32 v26, 2, v24
  v_lshlrev_b32 v104, 12, v26
  v_and_b32 v26, 3, v24
  v_lshl_add_u32 v104, v26, 8, v104
  v_xor_b32 v26, v24, v25
  v_lshl_add_u32 v104, v26, 4, v104
  v_xor_b32 v105, 64, v104
  v_xor_b32 v106, 128, v104
  v_xor_b32 v107, 192, v104
  v_lshlrev_b32 v108, 12, v25
  v_lshl_add_u32 v108, v24, 4, v108
  s_lshl_b32 s45, s3, 6
  s_add_u32 s45, s45, 131072
  v_lshl_add_u32 v109, v25, 4, s45
  v_lshlrev_b32 v111, 5, v24
  v_and_b32 v26, 1, v25
  v_lshl_add_u32 v111, v26, 4, v111
  v_lshrrev_b32 v26, 5, v0
  s_lshl_b32 s45, s3, 1
  v_add_lshl_u32 v26, v26, s45, 9
  v_add_u32 v111, v111, v26
  v_add_u32 v111, 147456, v111
  s_lshl_b32 s45, s3, 2
  v_add_lshl_u32 v112, v25, s45, 2
  v_add_u32 v112, 151552, v112
  s_mov_b32 s50, 115712
  s_mov_b32 s51, -1
  s_mov_b32 s52, 0
  v_add_u32 v114, 114688, v104
  v_add_u32 v115, 114688, v105
  v_add_u32 v116, 114688, v106
  v_add_u32 v117, 114688, v107
  s_waitcnt vmcnt(0) lgkmcnt(0)
  s_barrier
  ds_read_b128 a[0:3], v114
  ds_read_b128 a[4:7], v115
  ds_read_b128 a[8:11], v116
  ds_read_b128 a[12:15], v117
  v_add_u32 v114, s50, v104
  v_add_u32 v115, s50, v105
  v_add_u32 v116, s50, v106
  v_add_u32 v117, s50, v107
  s_waitcnt lgkmcnt(0)
  s_branch L_K1
L_slow:
  s_call_b64 s[66:67], L_init
  s_mov_b32 s45, 0x100000
L_sp:
  s_waitcnt lgkmcnt(0)
  s_mov_b64 s[62:63], 0
  s_atomic_add_x2 s[62:63], s[78:79], 8 glc
  s_waitcnt lgkmcnt(0)
  s_cmp_eq_u32 s63, 1
  s_cbranch_scc1 L_rdy
  s_sub_u32 s45, s45, 1
  s_cbranch_scc0 L_sp
  s_branch L_rdy
L_init:
  s_mov_b32 s45, 1
  s_atomic_add s45, s[78:79], 0 glc
  s_waitcnt lgkmcnt(0)
  s_cmp_eq_u32 s45, 0
  s_cbranch_scc0 L_iret
  s_mov_b32 s45, 1
  s_atomic_add s45, s[24:25], 0x7ff00 glc
  s_movk_i32 s48, 4352
  v_mul_lo_u32 v34, v0, s48
  v_mov_b32 v32, 0
  v_mov_b32 v33, 0
  s_mov_b32 s48, 262144
  s_mov_b32 exec_hi, 0
  buffer_store_dwordx2 v[32:33], v34, s[24:27], s48 offen sc1
  s_mov_b32 exec_hi, -1
  s_waitcnt vmcnt(0) lgkmcnt(0)
  s_add_u32 s48, s45, 1
  s_mov_b32 s49, 1
  s_atomic_swap_x2 s[48:49], s[78:79], 8
L_iret:
  s_setpc_b64 s[66:67]
.section .rodata,"a"
.p2align 6
.amdhsa_kernel standalone__linear_kernel_rfa__decode_kernel
  .amdhsa_next_free_vgpr 136
  .amdhsa_next_free_sgpr 88
  .amdhsa_accum_offset 120
  .amdhsa_group_segment_fixed_size 0
  .amdhsa_kernarg_size 56
  .amdhsa_user_sgpr_count 2
  .amdhsa_user_sgpr_kernarg_segment_ptr 1
  .amdhsa_system_sgpr_workgroup_id_x 1
  .amdhsa_float_denorm_mode_32 3
.end_amdhsa_kernel
```
